```python
import torch

def _softmax(x, axis=-1):
    return torch.softmax(x, dim=axis)
def _gelu(x):
    return torch.nn.functional.gelu(x, approximate="tanh")
def _silu(x):
    return torch.nn.functional.silu(x)
def _sigmoid(x):
    return torch.sigmoid(x)
def _layernorm(x, axis=-1, eps=1e-5):
    m = x.mean(dim=axis, keepdim=True)
    v = x.var(dim=axis, keepdim=True, unbiased=False)
    return (x - m) / torch.sqrt(v + eps)
def _scatter_add(tgt, idx, src, axis=0):
    return tgt.clone().index_add_(axis, idx, src)
def _segment_sum(src, seg, n):
    out = torch.zeros((n,) + src.shape[1:], dtype=src.dtype)
    return out.index_add_(0, seg, src)
def _pad(x, pw):
    flat = tuple(v for pair in reversed(pw) for v in pair)
    return torch.nn.functional.pad(x, flat)

kernel_name = 'parallel_sum__sliding_block_cached__mixer_token_mlp__decode'

def setup_inputs():

    _w = (lambda a: (lambda t: t.to(torch.bfloat16) if t.is_floating_point() else t)(torch.as_tensor(a)))
    def _A_setup():
        B, Sq, D = 4, 1, 512
        Hq, Hkv, Sk, Dh = 32, 32, 4096, 128
        assert Hq % Hkv == 0, (Hq, Hkv)
        return {
            "x": _w((lambda *s: torch.randn(*s, dtype=torch.bfloat16) * 0.05)(B, Sq, D)),
            "k_cache": _w((lambda *s: torch.randn(*s, dtype=torch.bfloat16) * 1.6)(B, Hkv, Sk, Dh)),
            "v_cache": _w((lambda *s: torch.randn(*s, dtype=torch.bfloat16) * 0.8)(B, Hkv, Sk, Dh)),
            "wq": _w((lambda *s: torch.randn(*s, dtype=torch.bfloat16) * 1.6)(D, Hq * Dh) * (D ** -0.5)),
            "wo": _w((lambda *s: torch.randn(*s, dtype=torch.bfloat16) * 0.8)(Hq * Dh, D) * ((Hq * Dh) ** -0.5)),
        }
    _A_in = _A_setup()

    def _B_setup():
        B, S, D, F = 4, 1, 512, 1376
        return {
            "x": _w((lambda *s: torch.randn(*s, dtype=torch.bfloat16) * 0.05)(B, S, D)),
            "w1": _w((lambda *s: torch.randn(*s, dtype=torch.bfloat16) * 3.2)(S, F) * (S ** -0.5)),
            "b1": _w((lambda *s: torch.randn(*s, dtype=torch.bfloat16) * 0.4)(F) * 0.02),
            "w2": _w((lambda *s: torch.randn(*s, dtype=torch.bfloat16) * 0.4)(F, S) * (F ** -0.5)),
            "b2": _w((lambda *s: torch.randn(*s, dtype=torch.bfloat16) * 0.4)(S) * 0.02),
        }
    _B_in = _B_setup()

    return {
        "A_x": _A_in["x"],
        "A_k_cache": _A_in["k_cache"],
        "A_v_cache": _A_in["v_cache"],
        "A_wq": _A_in["wq"],
        "A_wo": _A_in["wo"],
        "B_x": _B_in["x"],
        "B_w1": _B_in["w1"],
        "B_b1": _B_in["b1"],
        "B_w2": _B_in["w2"],
        "B_b2": _B_in["b2"],
    }

def reference(A_x, A_k_cache, A_v_cache, A_wq, A_wo, B_x, B_w1, B_b1, B_w2, B_b2):
    def _A_ref(x, k_cache, v_cache, wq, wo):
        B, Sq, D = x.shape
        Hq, Dh = 32, 128
        Hkv, Sk = k_cache.shape[1], k_cache.shape[2]
        W = min(4096, max(256, Sk // 4))
        rep = Hq // Hkv
        q = (lambda x, *d: x.permute(*d))((x @ wq).reshape(B, Sq, Hq, Dh), 0, 2, 1, 3)
        k = (lambda x, n, axis: torch.repeat_interleave(x, n, dim=axis))(k_cache[:, :, Sk - W:, :], rep, axis=1)
        v = (lambda x, n, axis: torch.repeat_interleave(x, n, dim=axis))(v_cache[:, :, Sk - W:, :], rep, axis=1)
        scores = torch.einsum("bhqd,bhkd->bhqk", q, k) * (Dh ** -0.5)
        p = _softmax(scores, axis=-1)
        o = torch.einsum("bhqk,bhkd->bhqd", p, v)
        return (lambda x, *d: x.permute(*d))(o, 0, 2, 1, 3).reshape(B, Sq, Hq * Dh) @ wo

    def _B_ref(x, w1, b1, w2, b2):
        B, S, D = x.shape
        h = _layernorm(x, axis=-1)
        u = torch.einsum("bsd,sf->bdf", h, w1) + b1
        u = _gelu(u)
        y = torch.einsum("bdf,fs->bds", u, w2) + b2
        return (lambda x, *d: x.permute(*d))(y, 0, 2, 1)

    x = A_x
    xn = _layernorm(x, axis=-1)
    return x + _A_ref(xn, A_k_cache, A_v_cache, A_wq, A_wo) + _B_ref(xn, B_w1, B_b1, B_w2, B_b2)
```

```asm
; @launch grid=(256,1,1) block=(512,1,1) lds=22528
.amdgcn_target "amdgcn-amd-amdhsa--gfx950"
.text
.globl parallel_sum__sliding_block_cached__mixer_token_mlp__decode_kernel
.p2align 8
.type parallel_sum__sliding_block_cached__mixer_token_mlp__decode_kernel,@function
parallel_sum__sliding_block_cached__mixer_token_mlp__decode_kernel:
    s_load_dwordx16 s[4:19], s[0:1], 0
    s_cmp_ge_u32 s2, 256
    s_cbranch_scc1 L_end
    v_cmp_gt_u32 vcc, 0x100, v0
    s_and_b32 s31, s2, 31
    s_lshr_b32 s33, s2, 6
    s_cbranch_vccz L_helper
    s_getpc_b64 s[40:41]
L_pc:
    v_lshlrev_b32 v4, 7, v0
    v_min_u32 v4, L_end-L_pc, v4
    global_load_dword v60, v4, s[40:41]
    v_lshlrev_b32 v3, 4, v0
    v_lshrrev_b32 v4, 2, v3
    v_xor_b32 v4, v4, v3
    v_and_b32 v4, 0xc0, v4
    v_lshl_or_b32 v4, v4, 2, v4
    v_xor_b32 v2, v3, v4
    s_lshl_b32 s3, s33, 5
    s_or_b32 s3, s3, s31
    s_lshl_b32 s3, s3, 3
    s_bfe_u32 s34, s2, 0x10005
    s_add_u32 s3, s3, s34
    s_add_u32 s3, s3, 6
    s_lshl_b32 s3, s3, 17
    s_mov_b32 s38, 0x20000
    s_mov_b32 s39, 0x20000
    s_mov_b32 s56, 0
    s_waitcnt lgkmcnt(0)
    s_add_u32 s36, s6, s3
    s_addc_u32 s37, s7, 0
    buffer_load_dwordx4 v[128:131], v2, s[36:39], s56 offen nt
    s_addk_i32 s56, 4096
    buffer_load_dwordx4 v[132:135], v2, s[36:39], s56 offen nt
    s_addk_i32 s56, 4096
    buffer_load_dwordx4 v[136:139], v2, s[36:39], s56 offen nt
    s_addk_i32 s56, 4096
    buffer_load_dwordx4 v[140:143], v2, s[36:39], s56 offen nt
    s_addk_i32 s56, 4096
    buffer_load_dwordx4 v[144:147], v2, s[36:39], s56 offen nt
    s_addk_i32 s56, 4096
    v_mov_b32 v7, 0
    v_mov_b32 v8, -1
    v_mov_b32 v9, -1
    v_mov_b32 v10, -1
    v_mov_b32 v11, -1
    ds_write_b128 v7, v[8:11] offset:17664
    ds_write_b128 v7, v[8:11] offset:17696
    ds_write_b64 v7, v[8:9] offset:17680
    s_add_u32 s40, s8, s3
    s_addc_u32 s41, s9, 0
    s_mov_b32 s42, 0x20000
    s_mov_b32 s43, 0x20000
    s_mov_b32 s57, 0
    v_lshrrev_b32 v1, 6, v0
    s_nop 0
    v_readfirstlane_b32 s30, v1
    s_mov_b32 s44, 0xaaaaaaaa
    s_mov_b32 s45, s44
    s_mov_b32 s46, 0xcccccccc
    s_mov_b32 s47, s46
    s_mov_b32 s48, 0xf000f
    s_mov_b32 s49, s48
    s_mov_b32 s50, 0xf000f0
    s_mov_b32 s51, s50
    s_mov_b32 s52, 0xf000f00
    s_mov_b32 s53, s52
    s_mov_b32 s54, 0xf000f000
    s_mov_b32 s55, s54
    v_mov_b32 v4, 0xffff
    v_mov_b32 v5, 0xffff0000
    v_cndmask_b32 v4, v4, v5, s[44:45]
    s_mov_b32 s58, 0x3030303
    s_mov_b32 s59, s58
    v_cndmask_b32 v24, 0, v4, s[58:59]
    s_mov_b32 s58, 0xc0c0c0c
    s_mov_b32 s59, s58
    v_cndmask_b32 v25, 0, v4, s[58:59]
    s_mov_b32 s58, 0x30303030
    s_mov_b32 s59, s58
    v_cndmask_b32 v26, 0, v4, s[58:59]
    s_mov_b32 s58, 0xc0c0c0c0
    s_mov_b32 s59, s58
    v_cndmask_b32 v27, 0, v4, s[58:59]
    v_bfe_u32 v5, v0, 4, 2
    v_and_b32 v6, 3, v0
    v_lshlrev_b32 v4, 6, v5
    v_lshl_or_b32 v4, v6, 4, v4
    v_and_b32 v6, 15, v0
    v_lshlrev_b32 v6, 5, v6
    v_bfe_u32 v5, v0, 4, 1
    v_lshl_or_b32 v6, v5, 4, v6
    v_lshrrev_b32 v5, 5, v0
    v_lshl_or_b32 v5, v5, 9, v6
    v_lshlrev_b32 v6, 2, v1
    s_mov_b32 s60, 0x3db504f3
    s_mov_b32 s61, 0x3fb8aa3b
    s_mov_b32 s62, 0
    s_mov_b32 s63, -1
    s_mov_b32 s64, s12
    s_mov_b32 s65, s13
    s_mov_b32 s66, 0x400000
    s_mov_b32 s67, 0x20000
    v_lshrrev_b32 v1, 3, v0
    v_and_b32 v1, 7, v1
    v_lshlrev_b32 v1, 10, v1
    v_and_b32 v59, 7, v0
    v_lshl_or_b32 v1, v59, 4, v1
    s_lshl_b32 s3, s31, 17
    s_lshr_b32 s32, s2, 5
    s_lshl_b32 s32, s32, 7
    s_add_u32 s3, s3, s32
    s_lshl_b32 s32, s30, 15
    s_add_u32 s35, s3, s32
    s_lshl_b32 s34, s30, 12
    s_waitcnt vmcnt(4)
    buffer_load_dwordx4 v[148:151], v2, s[36:39], s56 offen nt
    s_addk_i32 s56, 4096
    s_waitcnt vmcnt(4)
    buffer_load_dwordx4 v[152:155], v2, s[36:39], s56 offen nt
    s_addk_i32 s56, 4096
    s_waitcnt vmcnt(4)
    buffer_load_dwordx4 v[156:159], v2, s[36:39], s56 offen nt
    s_addk_i32 s56, 4096
    s_waitcnt vmcnt(4)
    buffer_load_dwordx4 v[160:163], v2, s[36:39], s56 offen nt
    s_addk_i32 s56, 4096
    s_waitcnt vmcnt(4)
    buffer_load_dwordx4 v[164:167], v2, s[36:39], s56 offen nt
    s_addk_i32 s56, 4096
    s_waitcnt vmcnt(4)
    buffer_load_dwordx4 v[168:171], v2, s[36:39], s56 offen nt
    s_addk_i32 s56, 4096
    s_waitcnt vmcnt(4)
    buffer_load_dwordx4 v[172:175], v2, s[36:39], s56 offen nt
    s_addk_i32 s56, 4096
    s_waitcnt vmcnt(4)
    buffer_load_dwordx4 v[176:179], v2, s[36:39], s56 offen nt
    s_addk_i32 s56, 4096
    s_waitcnt vmcnt(4)
    buffer_load_dwordx4 v[180:183], v2, s[36:39], s56 offen nt
    s_addk_i32 s56, 4096
    s_waitcnt vmcnt(4)
    buffer_load_dwordx4 v[184:187], v2, s[36:39], s56 offen nt
    s_addk_i32 s56, 4096
    s_waitcnt vmcnt(4)
    buffer_load_dwordx4 v[188:191], v2, s[36:39], s56 offen nt
    s_addk_i32 s56, 4096
    s_waitcnt vmcnt(4)
    buffer_load_dwordx4 v[192:195], v2, s[36:39], s56 offen nt
    s_addk_i32 s56, 4096
    s_waitcnt vmcnt(4)
    buffer_load_dwordx4 v[196:199], v2, s[36:39], s56 offen nt
    s_addk_i32 s56, 4096
    s_waitcnt vmcnt(4)
    buffer_load_dwordx4 v[200:203], v2, s[36:39], s56 offen nt
    s_addk_i32 s56, 4096
    s_waitcnt vmcnt(4)
    buffer_load_dwordx4 v[204:207], v2, s[36:39], s56 offen nt
    s_addk_i32 s56, 4096
    s_waitcnt vmcnt(4)
    buffer_load_dwordx4 v[208:211], v2, s[36:39], s56 offen nt
    s_addk_i32 s56, 4096
    s_waitcnt vmcnt(4)
    buffer_load_dwordx4 v[212:215], v2, s[36:39], s56 offen nt
    s_addk_i32 s56, 4096
    s_waitcnt vmcnt(4)
    buffer_load_dwordx4 v[216:219], v2, s[36:39], s56 offen nt
    s_addk_i32 s56, 4096
    s_waitcnt vmcnt(4)
    buffer_load_dwordx4 v[220:223], v2, s[36:39], s56 offen nt
    s_addk_i32 s56, 4096
    s_waitcnt lgkmcnt(0)
    s_barrier
    s_waitcnt vmcnt(4)
    buffer_load_dwordx4 v[224:227], v2, s[36:39], s56 offen nt
    s_addk_i32 s56, 4096
    s_waitcnt vmcnt(4)
    buffer_load_dwordx4 v[228:231], v2, s[36:39], s56 offen nt
    s_addk_i32 s56, 4096
    s_waitcnt vmcnt(4)
    buffer_load_dwordx4 v[232:235], v2, s[36:39], s56 offen nt
    s_addk_i32 s56, 4096
    s_waitcnt vmcnt(4)
    buffer_load_dwordx4 v[236:239], v2, s[36:39], s56 offen nt
    s_addk_i32 s56, 4096
    s_waitcnt vmcnt(4)
    buffer_load_dwordx4 v[240:243], v2, s[36:39], s56 offen nt
    s_addk_i32 s56, 4096
    s_waitcnt vmcnt(4)
    buffer_load_dwordx4 v[244:247], v2, s[36:39], s56 offen nt
    s_addk_i32 s56, 4096
    s_waitcnt vmcnt(4)
    buffer_load_dwordx4 v[248:251], v2, s[36:39], s56 offen nt
    s_addk_i32 s56, 4096
    s_waitcnt vmcnt(4)
    buffer_load_dwordx4 v[252:255], v2, s[36:39], s56 offen nt
    s_addk_i32 s56, 4096
    s_waitcnt vmcnt(4)
    buffer_load_dwordx4 v[64:67], v3, s[40:43], s57 offen nt
    s_addk_i32 s57, 4096
    s_waitcnt vmcnt(4)
    buffer_load_dwordx4 v[68:71], v3, s[40:43], s57 offen nt
    s_addk_i32 s57, 4096
    s_waitcnt vmcnt(4)
    buffer_load_dwordx4 v[72:75], v3, s[40:43], s57 offen nt
    s_addk_i32 s57, 4096
    s_waitcnt vmcnt(4)
    buffer_load_dwordx4 v[76:79], v3, s[40:43], s57 offen nt
    s_addk_i32 s57, 4096
    s_waitcnt vmcnt(4)
    buffer_load_dwordx4 v[80:83], v3, s[40:43], s57 offen nt
    s_addk_i32 s57, 4096
    s_waitcnt vmcnt(4)
    buffer_load_dwordx4 v[84:87], v3, s[40:43], s57 offen nt
    s_addk_i32 s57, 4096
    s_waitcnt vmcnt(4)
    buffer_load_dwordx4 v[88:91], v3, s[40:43], s57 offen nt
    s_addk_i32 s57, 4096
    s_waitcnt vmcnt(4)
    buffer_load_dwordx4 v[92:95], v3, s[40:43], s57 offen nt
    s_addk_i32 s57, 4096
    s_waitcnt vmcnt(4)
L_qw:
    ds_read_b32 v61, v7 offset:17684
    ds_read_b128 v[8:11], v4 offset:17408
    s_waitcnt lgkmcnt(0)
    v_cmp_eq_u32 vcc, -1, v61
    s_cbranch_vccnz L_qw
    buffer_load_dwordx4 v[96:99], v3, s[40:43], s57 offen nt
    s_addk_i32 s57, 4096
    v_cndmask_b32 v20, 0, v8, s[54:55]
    v_cndmask_b32 v21, 0, v9, s[54:55]
    v_cndmask_b32 v22, 0, v10, s[54:55]
    v_cndmask_b32 v23, 0, v11, s[54:55]
    v_cndmask_b32 v16, 0, v8, s[52:53]
    v_cndmask_b32 v17, 0, v9, s[52:53]
    v_cndmask_b32 v18, 0, v10, s[52:53]
    v_cndmask_b32 v19, 0, v11, s[52:53]
    v_cndmask_b32 v12, 0, v8, s[50:51]
    v_cndmask_b32 v13, 0, v9, s[50:51]
    v_cndmask_b32 v14, 0, v10, s[50:51]
    v_cndmask_b32 v15, 0, v11, s[50:51]
    v_cndmask_b32 v8, 0, v8, s[48:49]
    v_cndmask_b32 v9, 0, v9, s[48:49]
    v_cndmask_b32 v10, 0, v10, s[48:49]
    v_cndmask_b32 v11, 0, v11, s[48:49]
    s_nop 1
    v_mfma_f32_16x16x32_bf16 v[28:31], v[128:131], v[8:11], 0
    v_mfma_f32_16x16x32_bf16 v[28:31], v[132:135], v[12:15], v[28:31]
    v_mfma_f32_16x16x32_bf16 v[28:31], v[136:139], v[16:19], v[28:31]
    v_mfma_f32_16x16x32_bf16 v[28:31], v[140:143], v[20:23], v[28:31]
    v_mfma_f32_16x16x32_bf16 v[32:35], v[144:147], v[8:11], 0
    v_mfma_f32_16x16x32_bf16 v[32:35], v[148:151], v[12:15], v[32:35]
    v_mfma_f32_16x16x32_bf16 v[32:35], v[152:155], v[16:19], v[32:35]
    v_mfma_f32_16x16x32_bf16 v[32:35], v[156:159], v[20:23], v[32:35]
    s_waitcnt vmcnt(4)
    buffer_load_dwordx4 v[100:103], v3, s[40:43], s57 offen nt
    s_addk_i32 s57, 4096
    v_mfma_f32_16x16x32_bf16 v[36:39], v[160:163], v[8:11], 0
    v_mfma_f32_16x16x32_bf16 v[36:39], v[164:167], v[12:15], v[36:39]
    v_mfma_f32_16x16x32_bf16 v[36:39], v[168:171], v[16:19], v[36:39]
    v_mfma_f32_16x16x32_bf16 v[36:39], v[172:175], v[20:23], v[36:39]
    s_waitcnt vmcnt(4)
    buffer_load_dwordx4 v[104:107], v3, s[40:43], s57 offen nt
    s_addk_i32 s57, 4096
    v_cndmask_b32 v28, v28, v29, s[44:45]
    v_cndmask_b32 v30, v30, v31, s[44:45]
    v_cndmask_b32 v28, v28, v30, s[46:47]
    v_mfma_f32_16x16x32_bf16 v[40:43], v[176:179], v[8:11], 0
    v_mfma_f32_16x16x32_bf16 v[40:43], v[180:183], v[12:15], v[40:43]
    v_mfma_f32_16x16x32_bf16 v[40:43], v[184:187], v[16:19], v[40:43]
    v_mfma_f32_16x16x32_bf16 v[40:43], v[188:191], v[20:23], v[40:43]
    s_waitcnt vmcnt(4)
    buffer_load_dwordx4 v[108:111], v3, s[40:43], s57 offen nt
    s_addk_i32 s57, 4096
    v_cndmask_b32 v32, v32, v33, s[44:45]
    v_cndmask_b32 v34, v34, v35, s[44:45]
    v_cndmask_b32 v32, v32, v34, s[46:47]
    v_mfma_f32_16x16x32_bf16 v[44:47], v[192:195], v[8:11], 0
    v_mfma_f32_16x16x32_bf16 v[44:47], v[196:199], v[12:15], v[44:47]
    v_mfma_f32_16x16x32_bf16 v[44:47], v[200:203], v[16:19], v[44:47]
    v_mfma_f32_16x16x32_bf16 v[44:47], v[204:207], v[20:23], v[44:47]
    s_waitcnt vmcnt(4)
    buffer_load_dwordx4 v[112:115], v3, s[40:43], s57 offen nt
    s_addk_i32 s57, 4096
    v_cndmask_b32 v36, v36, v37, s[44:45]
    v_cndmask_b32 v38, v38, v39, s[44:45]
    v_cndmask_b32 v36, v36, v38, s[46:47]
    v_mfma_f32_16x16x32_bf16 v[48:51], v[208:211], v[8:11], 0
    v_mfma_f32_16x16x32_bf16 v[48:51], v[212:215], v[12:15], v[48:51]
    v_mfma_f32_16x16x32_bf16 v[48:51], v[216:219], v[16:19], v[48:51]
    v_mfma_f32_16x16x32_bf16 v[48:51], v[220:223], v[20:23], v[48:51]
    s_waitcnt vmcnt(4)
    buffer_load_dwordx4 v[116:119], v3, s[40:43], s57 offen nt
    s_addk_i32 s57, 4096
    v_cndmask_b32 v40, v40, v41, s[44:45]
    v_cndmask_b32 v42, v42, v43, s[44:45]
    v_cndmask_b32 v40, v40, v42, s[46:47]
    v_mfma_f32_16x16x32_bf16 v[52:55], v[224:227], v[8:11], 0
    v_mfma_f32_16x16x32_bf16 v[52:55], v[228:231], v[12:15], v[52:55]
    v_mfma_f32_16x16x32_bf16 v[52:55], v[232:235], v[16:19], v[52:55]
    v_mfma_f32_16x16x32_bf16 v[52:55], v[236:239], v[20:23], v[52:55]
    s_waitcnt vmcnt(4)
    buffer_load_dwordx4 v[120:123], v3, s[40:43], s57 offen nt
    s_addk_i32 s57, 4096
    v_cndmask_b32 v44, v44, v45, s[44:45]
    v_cndmask_b32 v46, v46, v47, s[44:45]
    v_cndmask_b32 v44, v44, v46, s[46:47]
    v_mfma_f32_16x16x32_bf16 v[56:59], v[240:243], v[8:11], 0
    v_mfma_f32_16x16x32_bf16 v[56:59], v[244:247], v[12:15], v[56:59]
    v_mfma_f32_16x16x32_bf16 v[56:59], v[248:251], v[16:19], v[56:59]
    v_mfma_f32_16x16x32_bf16 v[56:59], v[252:255], v[20:23], v[56:59]
    s_waitcnt vmcnt(4)
    buffer_load_dwordx4 v[124:127], v3, s[40:43], s57 offen nt
    s_addk_i32 s57, 4096
    v_cndmask_b32 v48, v48, v49, s[44:45]
    v_cndmask_b32 v50, v50, v51, s[44:45]
    v_cndmask_b32 v48, v48, v50, s[46:47]
    v_cndmask_b32 v52, v52, v53, s[44:45]
    v_cndmask_b32 v54, v54, v55, s[44:45]
    v_cndmask_b32 v52, v52, v54, s[46:47]
    v_cndmask_b32 v56, v56, v57, s[44:45]
    v_cndmask_b32 v58, v58, v59, s[44:45]
    v_cndmask_b32 v56, v56, v58, s[46:47]
    v_add_f32 v28, v28, v28 quad_perm:[1,0,3,2] row_mask:0xf bank_mask:0xf
    v_add_f32 v32, v32, v32 quad_perm:[1,0,3,2] row_mask:0xf bank_mask:0xf
    v_add_f32 v36, v36, v36 quad_perm:[1,0,3,2] row_mask:0xf bank_mask:0xf
    v_add_f32 v40, v40, v40 quad_perm:[1,0,3,2] row_mask:0xf bank_mask:0xf
    v_add_f32 v44, v44, v44 quad_perm:[1,0,3,2] row_mask:0xf bank_mask:0xf
    v_add_f32 v48, v48, v48 quad_perm:[1,0,3,2] row_mask:0xf bank_mask:0xf
    v_add_f32 v52, v52, v52 quad_perm:[1,0,3,2] row_mask:0xf bank_mask:0xf
    v_add_f32 v56, v56, v56 quad_perm:[1,0,3,2] row_mask:0xf bank_mask:0xf
    v_add_f32 v28, v28, v28 quad_perm:[2,3,0,1] row_mask:0xf bank_mask:0xf
    v_add_f32 v32, v32, v32 quad_perm:[2,3,0,1] row_mask:0xf bank_mask:0xf
    v_add_f32 v36, v36, v36 quad_perm:[2,3,0,1] row_mask:0xf bank_mask:0xf
    v_add_f32 v40, v40, v40 quad_perm:[2,3,0,1] row_mask:0xf bank_mask:0xf
    v_add_f32 v44, v44, v44 quad_perm:[2,3,0,1] row_mask:0xf bank_mask:0xf
    v_add_f32 v48, v48, v48 quad_perm:[2,3,0,1] row_mask:0xf bank_mask:0xf
    v_add_f32 v52, v52, v52 quad_perm:[2,3,0,1] row_mask:0xf bank_mask:0xf
    v_add_f32 v56, v56, v56 quad_perm:[2,3,0,1] row_mask:0xf bank_mask:0xf
    s_waitcnt vmcnt(4)
    buffer_load_dwordx4 v[128:131], v3, s[40:43], s57 offen nt
    s_addk_i32 s57, 4096
    v_cvt_pk_bf16_f32 v28, v28, v32
    v_cvt_pk_bf16_f32 v36, v36, v40
    v_cvt_pk_bf16_f32 v44, v44, v48
    v_cvt_pk_bf16_f32 v52, v52, v56
    v_and_b32 v32, 0xffff0000, v28
    v_lshlrev_b32 v28, 16, v28
    v_mul_f32 v32, s60, v32
    v_mul_f32 v28, s60, v28
    v_cvt_pk_bf16_f32 v28, v28, v32
    v_and_b32 v32, 0xffff0000, v28
    v_lshlrev_b32 v28, 16, v28
    v_and_b32 v40, 0xffff0000, v36
    v_lshlrev_b32 v36, 16, v36
    v_mul_f32 v40, s60, v40
    v_mul_f32 v36, s60, v36
    v_cvt_pk_bf16_f32 v36, v36, v40
    v_and_b32 v40, 0xffff0000, v36
    v_lshlrev_b32 v36, 16, v36
    v_and_b32 v48, 0xffff0000, v44
    v_lshlrev_b32 v44, 16, v44
    v_mul_f32 v48, s60, v48
    v_mul_f32 v44, s60, v44
    v_cvt_pk_bf16_f32 v44, v44, v48
    v_and_b32 v48, 0xffff0000, v44
    v_lshlrev_b32 v44, 16, v44
    v_and_b32 v56, 0xffff0000, v52
    v_lshlrev_b32 v52, 16, v52
    v_mul_f32 v56, s60, v56
    v_mul_f32 v52, s60, v52
    v_cvt_pk_bf16_f32 v52, v52, v56
    v_and_b32 v56, 0xffff0000, v52
    v_lshlrev_b32 v52, 16, v52
    v_max3_f32 v60, v28, v32, v36
    v_max3_f32 v61, v40, v44, v48
    v_max3_f32 v60, v60, v52, v56
    v_max_f32 v60, v60, v61
    s_nop 1
    v_max_f32 v60, v60, v60 row_ror:4 row_mask:0xf bank_mask:0xf
    s_nop 1
    v_max_f32 v60, v60, v60 row_ror:8 row_mask:0xf bank_mask:0xf
    v_mov_b32 v61, v60
    s_nop 1
    v_permlane16_swap_b32 v60, v61
    v_max_f32 v60, v60, v61
    v_mov_b32 v61, v60
    s_nop 1
    v_permlane32_swap_b32 v60, v61
    v_max_f32 v60, v60, v61
    v_min_u32 v60, -2, v60
    ds_write_b32 v6, v60 offset:17664
    s_waitcnt vmcnt(4)
    buffer_load_dwordx4 v[132:135], v3, s[40:43], s57 offen nt
    s_addk_i32 s57, 4096
L_mw:
    ds_read_b128 v[60:63], v7 offset:17664
    s_waitcnt lgkmcnt(0)
    v_max3_u32 v8, v60, v61, v62
    v_max_u32 v8, v8, v63
    v_cmp_eq_u32 vcc, -1, v8
    s_cbranch_vccnz L_mw
    v_max3_f32 v60, v60, v61, v62
    v_max_f32 v60, v60, v63
    v_mul_f32 v60, s61, v60
    v_fma_f32 v28, v28, s61, -v60
    v_fma_f32 v32, v32, s61, -v60
    v_fma_f32 v36, v36, s61, -v60
    v_fma_f32 v40, v40, s61, -v60
    v_fma_f32 v44, v44, s61, -v60
    v_fma_f32 v48, v48, s61, -v60
    v_fma_f32 v52, v52, s61, -v60
    v_fma_f32 v56, v56, s61, -v60
    ds_write_b32 v7, v60 offset:17712
    v_exp_f32 v28, v28
    v_exp_f32 v32, v32
    v_exp_f32 v36, v36
    v_exp_f32 v40, v40
    v_exp_f32 v44, v44
    v_exp_f32 v48, v48
    v_exp_f32 v52, v52
    v_exp_f32 v56, v56
    v_cvt_pk_bf16_f32 v29, v28, v28
    v_cvt_pk_bf16_f32 v33, v32, v32
    v_cvt_pk_bf16_f32 v37, v36, v36
    v_cvt_pk_bf16_f32 v41, v40, v40
    v_cvt_pk_bf16_f32 v45, v44, v44
    v_cvt_pk_bf16_f32 v49, v48, v48
    v_cvt_pk_bf16_f32 v53, v52, v52
    v_cvt_pk_bf16_f32 v57, v56, v56
    s_waitcnt vmcnt(4)
    buffer_load_dwordx4 v[136:139], v3, s[40:43], s57 offen nt
    s_addk_i32 s57, 4096
    v_add_f32 v60, v28, v32
    v_add_f32 v61, v36, v40
    v_add_f32 v62, v44, v48
    v_add_f32 v63, v52, v56
    v_add_f32 v60, v60, v61
    v_add_f32 v62, v62, v63
    v_add_f32 v60, v60, v62
    s_nop 1
    v_add_f32 v60, v60, v60 row_ror:4 row_mask:0xf bank_mask:0xf
    s_nop 1
    v_add_f32 v60, v60, v60 row_ror:8 row_mask:0xf bank_mask:0xf
    v_mov_b32 v61, v60
    s_nop 1
    v_permlane16_swap_b32 v60, v61
    v_add_f32 v60, v60, v61
    v_mov_b32 v61, v60
    s_nop 1
    v_permlane32_swap_b32 v60, v61
    v_add_f32 v60, v60, v61
    v_min_u32 v60, -2, v60
    ds_write_b32 v6, v60 offset:17696
    v_and_b32 v8, v29, v24
    v_and_b32 v9, v29, v25
    v_and_b32 v10, v29, v26 row_shr:4 row_mask:0xf bank_mask:0xf bound_ctrl:1
    v_and_b32 v11, v29, v27 row_shr:4 row_mask:0xf bank_mask:0xf bound_ctrl:1
    v_and_b32 v12, v29, v24 row_shl:4 row_mask:0xf bank_mask:0xf bound_ctrl:1
    v_and_b32 v13, v29, v25 row_shl:4 row_mask:0xf bank_mask:0xf bound_ctrl:1
    v_and_b32 v14, v29, v26
    v_and_b32 v15, v29, v27
    s_waitcnt vmcnt(18)
    v_mfma_f32_16x16x32_bf16 v[16:19], v[8:11], v[64:67], 0
    s_waitcnt vmcnt(17)
    v_mfma_f32_16x16x32_bf16 v[16:19], v[12:15], v[68:71], v[16:19]
    s_waitcnt vmcnt(16)
    v_mfma_f32_16x16x32_bf16 v[20:23], v[8:11], v[72:75], 0
    s_waitcnt vmcnt(15)
    v_mfma_f32_16x16x32_bf16 v[20:23], v[12:15], v[76:79], v[20:23]
    v_and_b32 v8, v33, v24
    v_and_b32 v9, v33, v25
    v_and_b32 v10, v33, v26 row_shr:4 row_mask:0xf bank_mask:0xf bound_ctrl:1
    v_and_b32 v11, v33, v27 row_shr:4 row_mask:0xf bank_mask:0xf bound_ctrl:1
    v_and_b32 v12, v33, v24 row_shl:4 row_mask:0xf bank_mask:0xf bound_ctrl:1
    v_and_b32 v13, v33, v25 row_shl:4 row_mask:0xf bank_mask:0xf bound_ctrl:1
    v_and_b32 v14, v33, v26
    v_and_b32 v15, v33, v27
    s_waitcnt vmcnt(14)
    v_mfma_f32_16x16x32_bf16 v[16:19], v[8:11], v[80:83], v[16:19]
    s_waitcnt vmcnt(13)
    v_mfma_f32_16x16x32_bf16 v[16:19], v[12:15], v[84:87], v[16:19]
    s_waitcnt vmcnt(12)
    v_mfma_f32_16x16x32_bf16 v[20:23], v[8:11], v[88:91], v[20:23]
    s_waitcnt vmcnt(11)
    v_mfma_f32_16x16x32_bf16 v[20:23], v[12:15], v[92:95], v[20:23]
    v_and_b32 v8, v37, v24
    v_and_b32 v9, v37, v25
    v_and_b32 v10, v37, v26 row_shr:4 row_mask:0xf bank_mask:0xf bound_ctrl:1
    v_and_b32 v11, v37, v27 row_shr:4 row_mask:0xf bank_mask:0xf bound_ctrl:1
    v_and_b32 v12, v37, v24 row_shl:4 row_mask:0xf bank_mask:0xf bound_ctrl:1
    v_and_b32 v13, v37, v25 row_shl:4 row_mask:0xf bank_mask:0xf bound_ctrl:1
    v_and_b32 v14, v37, v26
    v_and_b32 v15, v37, v27
    s_waitcnt vmcnt(10)
    v_mfma_f32_16x16x32_bf16 v[16:19], v[8:11], v[96:99], v[16:19]
    s_waitcnt vmcnt(9)
    v_mfma_f32_16x16x32_bf16 v[16:19], v[12:15], v[100:103], v[16:19]
    buffer_load_dwordx4 v[140:143], v3, s[40:43], s57 offen nt
    s_addk_i32 s57, 4096
    s_waitcnt vmcnt(9)
    v_mfma_f32_16x16x32_bf16 v[20:23], v[8:11], v[104:107], v[20:23]
    buffer_load_dwordx4 v[144:147], v3, s[40:43], s57 offen nt
    s_addk_i32 s57, 4096
    s_waitcnt vmcnt(9)
    v_mfma_f32_16x16x32_bf16 v[20:23], v[12:15], v[108:111], v[20:23]
    v_and_b32 v8, v41, v24
    v_and_b32 v9, v41, v25
    v_and_b32 v10, v41, v26 row_shr:4 row_mask:0xf bank_mask:0xf bound_ctrl:1
    v_and_b32 v11, v41, v27 row_shr:4 row_mask:0xf bank_mask:0xf bound_ctrl:1
    v_and_b32 v12, v41, v24 row_shl:4 row_mask:0xf bank_mask:0xf bound_ctrl:1
    v_and_b32 v13, v41, v25 row_shl:4 row_mask:0xf bank_mask:0xf bound_ctrl:1
    v_and_b32 v14, v41, v26
    v_and_b32 v15, v41, v27
    buffer_load_dwordx4 v[148:151], v3, s[40:43], s57 offen nt
    s_addk_i32 s57, 4096
    s_waitcnt vmcnt(9)
    v_mfma_f32_16x16x32_bf16 v[16:19], v[8:11], v[112:115], v[16:19]
    buffer_load_dwordx4 v[152:155], v3, s[40:43], s57 offen nt
    s_addk_i32 s57, 4096
    s_waitcnt vmcnt(9)
    v_mfma_f32_16x16x32_bf16 v[16:19], v[12:15], v[116:119], v[16:19]
    buffer_load_dwordx4 v[156:159], v3, s[40:43], s57 offen nt
    s_addk_i32 s57, 4096
    s_waitcnt vmcnt(9)
    v_mfma_f32_16x16x32_bf16 v[20:23], v[8:11], v[120:123], v[20:23]
    buffer_load_dwordx4 v[160:163], v3, s[40:43], s57 offen nt
    s_addk_i32 s57, 4096
    s_waitcnt vmcnt(9)
    v_mfma_f32_16x16x32_bf16 v[20:23], v[12:15], v[124:127], v[20:23]
    v_and_b32 v8, v45, v24
    v_and_b32 v9, v45, v25
    v_and_b32 v10, v45, v26 row_shr:4 row_mask:0xf bank_mask:0xf bound_ctrl:1
    v_and_b32 v11, v45, v27 row_shr:4 row_mask:0xf bank_mask:0xf bound_ctrl:1
    v_and_b32 v12, v45, v24 row_shl:4 row_mask:0xf bank_mask:0xf bound_ctrl:1
    v_and_b32 v13, v45, v25 row_shl:4 row_mask:0xf bank_mask:0xf bound_ctrl:1
    v_and_b32 v14, v45, v26
    v_and_b32 v15, v45, v27
    buffer_load_dwordx4 v[164:167], v3, s[40:43], s57 offen nt
    s_addk_i32 s57, 4096
    s_waitcnt vmcnt(9)
    v_mfma_f32_16x16x32_bf16 v[16:19], v[8:11], v[128:131], v[16:19]
    buffer_load_dwordx4 v[168:171], v3, s[40:43], s57 offen nt
    s_addk_i32 s57, 4096
    s_waitcnt vmcnt(9)
    v_mfma_f32_16x16x32_bf16 v[16:19], v[12:15], v[132:135], v[16:19]
    buffer_load_dwordx4 v[172:175], v3, s[40:43], s57 offen nt
    s_addk_i32 s57, 4096
    s_waitcnt vmcnt(9)
    v_mfma_f32_16x16x32_bf16 v[20:23], v[8:11], v[136:139], v[20:23]
    buffer_load_dwordx4 v[176:179], v3, s[40:43], s57 offen nt
    s_addk_i32 s57, 4096
    s_waitcnt vmcnt(9)
    v_mfma_f32_16x16x32_bf16 v[20:23], v[12:15], v[140:143], v[20:23]
    v_and_b32 v8, v49, v24
    v_and_b32 v9, v49, v25
    v_and_b32 v10, v49, v26 row_shr:4 row_mask:0xf bank_mask:0xf bound_ctrl:1
    v_and_b32 v11, v49, v27 row_shr:4 row_mask:0xf bank_mask:0xf bound_ctrl:1
    v_and_b32 v12, v49, v24 row_shl:4 row_mask:0xf bank_mask:0xf bound_ctrl:1
    v_and_b32 v13, v49, v25 row_shl:4 row_mask:0xf bank_mask:0xf bound_ctrl:1
    v_and_b32 v14, v49, v26
    v_and_b32 v15, v49, v27
    buffer_load_dwordx4 v[180:183], v3, s[40:43], s57 offen nt
    s_addk_i32 s57, 4096
    s_waitcnt vmcnt(9)
    v_mfma_f32_16x16x32_bf16 v[16:19], v[8:11], v[144:147], v[16:19]
    buffer_load_dwordx4 v[184:187], v3, s[40:43], s57 offen nt
    s_addk_i32 s57, 4096
    s_waitcnt vmcnt(9)
    v_mfma_f32_16x16x32_bf16 v[16:19], v[12:15], v[148:151], v[16:19]
    buffer_load_dwordx4 v[188:191], v3, s[40:43], s57 offen nt
    s_addk_i32 s57, 4096
    s_add_u32 m0, s34, 0
    s_nop 0
    buffer_load_dwordx4 v1, s[64:67], s35 offen nt lds
    s_addk_i32 s35, 8192
    s_add_u32 m0, s34, 1024
    s_nop 0
    buffer_load_dwordx4 v1, s[64:67], s35 offen nt lds
    s_addk_i32 s35, 8192
    s_add_u32 m0, s34, 2048
    s_nop 0
    buffer_load_dwordx4 v1, s[64:67], s35 offen nt lds
    s_addk_i32 s35, 8192
    s_add_u32 m0, s34, 3072
    s_nop 0
    buffer_load_dwordx4 v1, s[64:67], s35 offen nt lds
    s_waitcnt vmcnt(13)
    v_mfma_f32_16x16x32_bf16 v[20:23], v[8:11], v[152:155], v[20:23]
    s_waitcnt vmcnt(12)
    v_mfma_f32_16x16x32_bf16 v[20:23], v[12:15], v[156:159], v[20:23]
    v_and_b32 v8, v53, v24
    v_and_b32 v9, v53, v25
    v_and_b32 v10, v53, v26 row_shr:4 row_mask:0xf bank_mask:0xf bound_ctrl:1
    v_and_b32 v11, v53, v27 row_shr:4 row_mask:0xf bank_mask:0xf bound_ctrl:1
    v_and_b32 v12, v53, v24 row_shl:4 row_mask:0xf bank_mask:0xf bound_ctrl:1
    v_and_b32 v13, v53, v25 row_shl:4 row_mask:0xf bank_mask:0xf bound_ctrl:1
    v_and_b32 v14, v53, v26
    v_and_b32 v15, v53, v27
    s_waitcnt vmcnt(11)
    v_mfma_f32_16x16x32_bf16 v[16:19], v[8:11], v[160:163], v[16:19]
    s_waitcnt vmcnt(10)
    v_mfma_f32_16x16x32_bf16 v[16:19], v[12:15], v[164:167], v[16:19]
    s_waitcnt vmcnt(9)
    v_mfma_f32_16x16x32_bf16 v[20:23], v[8:11], v[168:171], v[20:23]
    s_waitcnt vmcnt(8)
    v_mfma_f32_16x16x32_bf16 v[20:23], v[12:15], v[172:175], v[20:23]
    v_and_b32 v8, v57, v24
    v_and_b32 v9, v57, v25
    v_and_b32 v10, v57, v26 row_shr:4 row_mask:0xf bank_mask:0xf bound_ctrl:1
    v_and_b32 v11, v57, v27 row_shr:4 row_mask:0xf bank_mask:0xf bound_ctrl:1
    v_and_b32 v12, v57, v24 row_shl:4 row_mask:0xf bank_mask:0xf bound_ctrl:1
    v_and_b32 v13, v57, v25 row_shl:4 row_mask:0xf bank_mask:0xf bound_ctrl:1
    v_and_b32 v14, v57, v26
    v_and_b32 v15, v57, v27
    s_waitcnt vmcnt(7)
    v_mfma_f32_16x16x32_bf16 v[16:19], v[8:11], v[176:179], v[16:19]
    s_waitcnt vmcnt(6)
    v_mfma_f32_16x16x32_bf16 v[16:19], v[12:15], v[180:183], v[16:19]
    s_waitcnt vmcnt(5)
    v_mfma_f32_16x16x32_bf16 v[20:23], v[8:11], v[184:187], v[20:23]
    s_waitcnt vmcnt(4)
    v_mfma_f32_16x16x32_bf16 v[20:23], v[12:15], v[188:191], v[20:23]
    s_nop 7
    v_cndmask_b32 v16, v16, v20, s[62:63]
    v_cndmask_b32 v17, v17, v21, s[62:63]
    v_cndmask_b32 v18, v18, v22, s[62:63]
    v_cndmask_b32 v19, v19, v23, s[62:63]
    ds_write_b128 v5, v[16:19] offset:18432
    s_waitcnt lgkmcnt(0)
    s_barrier
    s_waitcnt vmcnt(0)
    s_barrier
    s_endpgm
L_helper:
    s_load_dwordx8 s[20:27], s[0:1], 64
    s_load_dwordx2 s[28:29], s[0:1], 96
    v_lshrrev_b32 v1, 6, v0
    v_and_b32 v0, 63, v0
    v_readfirstlane_b32 s30, v1
    v_and_b32 v2, 15, v0
    v_lshrrev_b32 v3, 4, v0
    v_mov_b32 v7, 0
    s_lshr_b32 s32, s2, 5
    s_sub_u32 s45, s30, 4
    s_lshl_b32 s46, s31, 13
    s_add_u32 s46, s46, 262144
    s_cmp_lg_u32 s30, 4
    s_cbranch_scc1 L_gelu
    s_setprio 3
    v_lshrrev_b32 v4, 2, v2
    v_lshlrev_b32 v4, 10, v4
    v_and_b32 v5, 3, v0
    v_lshl_or_b32 v4, v5, 6, v4
    v_lshl_or_b32 v4, v3, 4, v4
    s_lshr_b32 s52, s32, 1
    s_and_b32 s53, s32, 1
    s_lshl_b32 s3, s52, 8
    v_add_u32 v6, s3, v4
    v_lshrrev_b32 v8, 3, v0
    v_lshlrev_b32 v8, 13, v8
    v_and_b32 v9, 7, v0
    v_lshl_or_b32 v8, v9, 4, v8
    s_lshl_b32 s56, s52, 20
    s_lshl_b32 s44, s31, 8
    s_add_u32 s56, s56, s44
    s_lshl_b32 s44, s53, 7
    s_add_u32 s56, s56, s44
    s_mov_b32 s38, 0x400000
    s_mov_b32 s39, 0x20000
    s_mov_b32 s44, 0
    s_waitcnt lgkmcnt(0)
    s_mov_b32 s36, s10
    s_mov_b32 s37, s11
    global_load_dwordx4 v[16:19], v4, s[4:5] offset:0
    global_load_dwordx4 v[20:23], v4, s[4:5] offset:256
    global_load_dwordx4 v[24:27], v4, s[4:5] offset:512
    global_load_dwordx4 v[28:31], v4, s[4:5] offset:768
    global_load_dwordx4 v[32:35], v6, s[4:5]
    global_load_dword v10, v7, s[28:29] sc1
L_wq:
    s_mov_b32 m0, s44
    s_addk_i32 s44, 1024
    buffer_load_dwordx4 v8, s[36:39], s56 offen nt lds
    s_add_u32 s56, s56, 0x10000
    s_cmp_lt_u32 s44, 16384
    s_cbranch_scc1 L_wq
    s_lshl_b32 s44, s32, 10
    s_add_u32 s3, s46, s44
    v_lshl_add_u32 v11, v0, 4, s3
    v_mov_b32 v56, -1
    v_mov_b32 v57, -1
    v_mov_b32 v58, -1
    v_mov_b32 v59, -1
    s_mov_b32 exec_lo, 0xffffff
    s_mov_b32 exec_hi, 0
    global_store_dwordx4 v11, v[56:59], s[28:29]
    s_mov_b64 exec, -1
    s_getreg_b32 s47, hwreg(HW_REG_XCC_ID, 0, 3)
    v_lshrrev_b32 v4, 2, v2
    v_lshl_add_u32 v4, v3, 3, v4
    v_lshlrev_b32 v4, 7, v4
    v_lshl_or_b32 v4, v5, 3, v4
    s_lshl_b32 s3, s31, 13
    s_add_u32 s3, s3, 1048576
    s_lshl_b32 s44, s53, 2
    s_add_u32 s44, s44, s52
    s_lshl_b32 s44, s44, 8
    s_add_u32 s44, s44, s3
    v_lshlrev_b32 v5, 11, v3
    v_lshl_or_b32 v5, v2, 4, v5
    v_add_u32 v5, s44, v5
    s_lshl_b32 s44, s33, 11
    s_add_u32 s44, s44, s3
    v_lshl_add_u32 v6, v0, 4, s44
    s_waitcnt vmcnt(18)
    v_lshlrev_b32 v64, 16, v16
    v_and_b32 v65, 0xffff0000, v16
    v_lshlrev_b32 v66, 16, v17
    v_and_b32 v67, 0xffff0000, v17
    v_lshlrev_b32 v68, 16, v18
    v_and_b32 v69, 0xffff0000, v18
    v_lshlrev_b32 v70, 16, v19
    v_and_b32 v71, 0xffff0000, v19
    v_lshlrev_b32 v72, 16, v20
    v_and_b32 v73, 0xffff0000, v20
    v_lshlrev_b32 v74, 16, v21
    v_and_b32 v75, 0xffff0000, v21
    v_lshlrev_b32 v76, 16, v22
    v_and_b32 v77, 0xffff0000, v22
    v_lshlrev_b32 v78, 16, v23
    v_and_b32 v79, 0xffff0000, v23
    v_lshlrev_b32 v80, 16, v24
    v_and_b32 v81, 0xffff0000, v24
    v_lshlrev_b32 v82, 16, v25
    v_and_b32 v83, 0xffff0000, v25
    v_lshlrev_b32 v84, 16, v26
    v_and_b32 v85, 0xffff0000, v26
    v_lshlrev_b32 v86, 16, v27
    v_and_b32 v87, 0xffff0000, v27
    v_lshlrev_b32 v88, 16, v28
    v_and_b32 v89, 0xffff0000, v28
    v_lshlrev_b32 v90, 16, v29
    v_and_b32 v91, 0xffff0000, v29
    v_lshlrev_b32 v92, 16, v30
    v_and_b32 v93, 0xffff0000, v30
    v_lshlrev_b32 v94, 16, v31
    v_and_b32 v95, 0xffff0000, v31
    v_pk_add_f32 v[36:37], v[64:65], v[66:67]
    v_pk_add_f32 v[38:39], v[68:69], v[70:71]
    v_pk_add_f32 v[36:37], v[36:37], v[72:73]
    v_pk_add_f32 v[38:39], v[38:39], v[74:75]
    v_pk_add_f32 v[36:37], v[36:37], v[76:77]
    v_pk_add_f32 v[38:39], v[38:39], v[78:79]
    v_pk_add_f32 v[36:37], v[36:37], v[80:81]
    v_pk_add_f32 v[38:39], v[38:39], v[82:83]
    v_pk_add_f32 v[36:37], v[36:37], v[84:85]
    v_pk_add_f32 v[38:39], v[38:39], v[86:87]
    v_pk_add_f32 v[36:37], v[36:37], v[88:89]
    v_pk_add_f32 v[38:39], v[38:39], v[90:91]
    v_pk_add_f32 v[36:37], v[36:37], v[92:93]
    v_pk_add_f32 v[38:39], v[38:39], v[94:95]
    v_pk_add_f32 v[36:37], v[36:37], v[38:39]
    v_add_f32 v36, v36, v37
    s_nop 1
    v_add_f32 v36, v36, v36 quad_perm:[1,0,3,2] row_mask:0xf bank_mask:0xf
    s_nop 1
    v_add_f32 v36, v36, v36 quad_perm:[2,3,0,1] row_mask:0xf bank_mask:0xf
    v_mov_b32 v37, v36
    s_nop 1
    v_permlane16_swap_b32 v36, v37
    v_add_f32 v36, v36, v37
    v_mov_b32 v37, v36
    s_nop 1
    v_permlane32_swap_b32 v36, v37
    v_add_f32 v36, v36, v37
    v_mul_f32 v36, 0x3b000000, v36
    v_mov_b32 v37, v36
    v_pk_add_f32 v[64:65], v[64:65], v[36:37] neg_lo:[0,1] neg_hi:[0,1]
    v_pk_add_f32 v[66:67], v[66:67], v[36:37] neg_lo:[0,1] neg_hi:[0,1]
    v_pk_add_f32 v[68:69], v[68:69], v[36:37] neg_lo:[0,1] neg_hi:[0,1]
    v_pk_add_f32 v[70:71], v[70:71], v[36:37] neg_lo:[0,1] neg_hi:[0,1]
    v_pk_add_f32 v[72:73], v[72:73], v[36:37] neg_lo:[0,1] neg_hi:[0,1]
    v_pk_add_f32 v[74:75], v[74:75], v[36:37] neg_lo:[0,1] neg_hi:[0,1]
    v_pk_add_f32 v[76:77], v[76:77], v[36:37] neg_lo:[0,1] neg_hi:[0,1]
    v_pk_add_f32 v[78:79], v[78:79], v[36:37] neg_lo:[0,1] neg_hi:[0,1]
    v_pk_add_f32 v[80:81], v[80:81], v[36:37] neg_lo:[0,1] neg_hi:[0,1]
    v_pk_add_f32 v[82:83], v[82:83], v[36:37] neg_lo:[0,1] neg_hi:[0,1]
    v_pk_add_f32 v[84:85], v[84:85], v[36:37] neg_lo:[0,1] neg_hi:[0,1]
    v_pk_add_f32 v[86:87], v[86:87], v[36:37] neg_lo:[0,1] neg_hi:[0,1]
    v_pk_add_f32 v[88:89], v[88:89], v[36:37] neg_lo:[0,1] neg_hi:[0,1]
    v_pk_add_f32 v[90:91], v[90:91], v[36:37] neg_lo:[0,1] neg_hi:[0,1]
    v_pk_add_f32 v[92:93], v[92:93], v[36:37] neg_lo:[0,1] neg_hi:[0,1]
    v_pk_add_f32 v[94:95], v[94:95], v[36:37] neg_lo:[0,1] neg_hi:[0,1]
    v_pk_mul_f32 v[38:39], v[64:65], v[64:65]
    v_pk_mul_f32 v[40:41], v[66:67], v[66:67]
    v_pk_fma_f32 v[38:39], v[68:69], v[68:69], v[38:39]
    v_pk_fma_f32 v[40:41], v[70:71], v[70:71], v[40:41]
    v_pk_fma_f32 v[38:39], v[72:73], v[72:73], v[38:39]
    v_pk_fma_f32 v[40:41], v[74:75], v[74:75], v[40:41]
    v_pk_fma_f32 v[38:39], v[76:77], v[76:77], v[38:39]
    v_pk_fma_f32 v[40:41], v[78:79], v[78:79], v[40:41]
    v_pk_fma_f32 v[38:39], v[80:81], v[80:81], v[38:39]
    v_pk_fma_f32 v[40:41], v[82:83], v[82:83], v[40:41]
    v_pk_fma_f32 v[38:39], v[84:85], v[84:85], v[38:39]
    v_pk_fma_f32 v[40:41], v[86:87], v[86:87], v[40:41]
    v_pk_fma_f32 v[38:39], v[88:89], v[88:89], v[38:39]
    v_pk_fma_f32 v[40:41], v[90:91], v[90:91], v[40:41]
    v_pk_fma_f32 v[38:39], v[92:93], v[92:93], v[38:39]
    v_pk_fma_f32 v[40:41], v[94:95], v[94:95], v[40:41]
    v_pk_add_f32 v[38:39], v[38:39], v[40:41]
    v_add_f32 v38, v38, v39
    s_nop 1
    v_add_f32 v38, v38, v38 quad_perm:[1,0,3,2] row_mask:0xf bank_mask:0xf
    s_nop 1
    v_add_f32 v38, v38, v38 quad_perm:[2,3,0,1] row_mask:0xf bank_mask:0xf
    v_mov_b32 v39, v38
    s_nop 1
    v_permlane16_swap_b32 v38, v39
    v_add_f32 v38, v38, v39
    v_mov_b32 v39, v38
    s_nop 1
    v_permlane32_swap_b32 v38, v39
    v_add_f32 v38, v38, v39
    v_mul_f32 v38, 0x3b000000, v38
    v_cvt_pk_bf16_f32 v36, v36, v36
    v_and_b32 v36, 0xffff0000, v36
    v_cvt_pk_bf16_f32 v38, v38, v38
    v_and_b32 v38, 0xffff0000, v38
    v_add_f32 v38, 0x3727c5ac, v38
    v_cvt_pk_bf16_f32 v38, v38, v38
    v_and_b32 v38, 0xffff0000, v38
    v_sqrt_f32 v38, v38
    s_nop 0
    v_cvt_pk_bf16_f32 v38, v38, v38
    v_and_b32 v38, 0xffff0000, v38
    v_rcp_f32 v38, v38
    v_lshlrev_b32 v40, 16, v32
    v_and_b32 v41, 0xffff0000, v32
    v_lshlrev_b32 v42, 16, v33
    v_and_b32 v43, 0xffff0000, v33
    v_lshlrev_b32 v44, 16, v34
    v_and_b32 v45, 0xffff0000, v34
    v_lshlrev_b32 v46, 16, v35
    v_and_b32 v47, 0xffff0000, v35
    v_sub_f32 v40, v40, v36
    v_sub_f32 v41, v41, v36
    v_sub_f32 v42, v42, v36
    v_sub_f32 v43, v43, v36
    v_sub_f32 v44, v44, v36
    v_sub_f32 v45, v45, v36
    v_sub_f32 v46, v46, v36
    v_sub_f32 v47, v47, v36
    v_cvt_pk_bf16_f32 v32, v40, v41
    v_cvt_pk_bf16_f32 v33, v42, v43
    v_cvt_pk_bf16_f32 v34, v44, v45
    v_cvt_pk_bf16_f32 v35, v46, v47
    v_lshlrev_b32 v40, 16, v32
    v_and_b32 v41, 0xffff0000, v32
    v_lshlrev_b32 v42, 16, v33
    v_and_b32 v43, 0xffff0000, v33
    v_lshlrev_b32 v44, 16, v34
    v_and_b32 v45, 0xffff0000, v34
    v_lshlrev_b32 v46, 16, v35
    v_and_b32 v47, 0xffff0000, v35
    v_mul_f32 v40, v40, v38
    v_mul_f32 v41, v41, v38
    v_mul_f32 v42, v42, v38
    v_mul_f32 v43, v43, v38
    v_mul_f32 v44, v44, v38
    v_mul_f32 v45, v45, v38
    v_mul_f32 v46, v46, v38
    v_mul_f32 v47, v47, v38
    v_cvt_pk_bf16_f32 v32, v40, v41
    v_cvt_pk_bf16_f32 v33, v42, v43
    v_cvt_pk_bf16_f32 v34, v44, v45
    v_cvt_pk_bf16_f32 v35, v46, v47
    s_movk_i32 s51, 0x3f
    s_waitcnt vmcnt(0)
    v_readfirstlane_b32 s48, v10
    ds_read_b64_tr_b16 v[128:129], v4 offset:0
    ds_read_b64_tr_b16 v[130:131], v4 offset:512
    ds_read_b64_tr_b16 v[132:133], v4 offset:4096
    ds_read_b64_tr_b16 v[134:135], v4 offset:4608
    ds_read_b64_tr_b16 v[136:137], v4 offset:8192
    ds_read_b64_tr_b16 v[138:139], v4 offset:8704
    ds_read_b64_tr_b16 v[140:141], v4 offset:12288
    ds_read_b64_tr_b16 v[142:143], v4 offset:12800
    ds_read_b64_tr_b16 v[144:145], v4 offset:32
    ds_read_b64_tr_b16 v[146:147], v4 offset:544
    ds_read_b64_tr_b16 v[148:149], v4 offset:4128
    ds_read_b64_tr_b16 v[150:151], v4 offset:4640
    ds_read_b64_tr_b16 v[152:153], v4 offset:8224
    ds_read_b64_tr_b16 v[154:155], v4 offset:8736
    ds_read_b64_tr_b16 v[156:157], v4 offset:12320
    ds_read_b64_tr_b16 v[158:159], v4 offset:12832
    ds_read_b64_tr_b16 v[160:161], v4 offset:64
    ds_read_b64_tr_b16 v[162:163], v4 offset:576
    ds_read_b64_tr_b16 v[164:165], v4 offset:4160
    ds_read_b64_tr_b16 v[166:167], v4 offset:4672
    ds_read_b64_tr_b16 v[168:169], v4 offset:8256
    ds_read_b64_tr_b16 v[170:171], v4 offset:8768
    ds_read_b64_tr_b16 v[172:173], v4 offset:12352
    ds_read_b64_tr_b16 v[174:175], v4 offset:12864
    ds_read_b64_tr_b16 v[176:177], v4 offset:96
    ds_read_b64_tr_b16 v[178:179], v4 offset:608
    ds_read_b64_tr_b16 v[180:181], v4 offset:4192
    ds_read_b64_tr_b16 v[182:183], v4 offset:4704
    ds_read_b64_tr_b16 v[184:185], v4 offset:8288
    ds_read_b64_tr_b16 v[186:187], v4 offset:8800
    ds_read_b64_tr_b16 v[188:189], v4 offset:12384
    ds_read_b64_tr_b16 v[190:191], v4 offset:12896
    s_add_u32 s48, s48, 0x9e3779a9
    s_xor_b32 s49, s48, s47
    v_mov_b32 v9, s49
    s_waitcnt lgkmcnt(15)
    v_mfma_f32_16x16x32_bf16 v[64:67], v[32:35], v[128:131], 0
    v_mfma_f32_16x16x32_bf16 v[68:71], v[32:35], v[132:135], 0
    v_mfma_f32_16x16x32_bf16 v[72:75], v[32:35], v[136:139], 0
    v_mfma_f32_16x16x32_bf16 v[76:79], v[32:35], v[140:143], 0
    s_waitcnt lgkmcnt(15)
    v_mfma_f32_16x16x32_bf16 v[80:83], v[32:35], v[144:147], 0
    v_mfma_f32_16x16x32_bf16 v[84:87], v[32:35], v[148:151], 0
    v_mfma_f32_16x16x32_bf16 v[88:91], v[32:35], v[152:155], 0
    v_mfma_f32_16x16x32_bf16 v[92:95], v[32:35], v[156:159], 0
    s_waitcnt lgkmcnt(8)
    v_mfma_f32_16x16x32_bf16 v[96:99], v[32:35], v[160:163], 0
    v_mfma_f32_16x16x32_bf16 v[100:103], v[32:35], v[164:167], 0
    v_mfma_f32_16x16x32_bf16 v[104:107], v[32:35], v[168:171], 0
    v_mfma_f32_16x16x32_bf16 v[108:111], v[32:35], v[172:175], 0
    s_waitcnt lgkmcnt(0)
    v_mfma_f32_16x16x32_bf16 v[112:115], v[32:35], v[176:179], 0
    v_mfma_f32_16x16x32_bf16 v[116:119], v[32:35], v[180:183], 0
    v_mfma_f32_16x16x32_bf16 v[120:123], v[32:35], v[184:187], 0
    v_mfma_f32_16x16x32_bf16 v[124:127], v[32:35], v[188:191], 0
    s_mov_b32 s44, 0
    s_mov_b32 s50, 0
    v_add_f32 v48, v64, v69
    v_add_f32 v52, v74, v79
    v_add_f32 v48, v48, v52
    v_add_f32 v49, v80, v85
    v_add_f32 v52, v90, v95
    v_add_f32 v49, v49, v52
    v_add_f32 v50, v96, v101
    v_add_f32 v52, v106, v111
    v_add_f32 v50, v50, v52
    v_add_f32 v51, v112, v117
    v_add_f32 v52, v122, v127
    v_add_f32 v51, v51, v52
    v_bfi_b32 v48, s51, v9, v48
    v_bfi_b32 v49, s51, v9, v49
    v_bfi_b32 v50, s51, v9, v50
    v_bfi_b32 v51, s51, v9, v51
    global_store_dwordx4 v5, v[48:51], s[28:29]
    s_barrier
L_qpoll:
    global_load_dwordx4 v[128:131], v6, s[28:29] offset:0 nt
    global_load_dwordx4 v[132:135], v6, s[28:29] offset:1024 nt
L_qchk:
    s_add_u32 s44, s44, 1
    s_waitcnt vmcnt(0)
    v_xor_b32 v12, v128, v9
    v_xor_b32 v13, v129, v9
    v_xor_b32 v14, v130, v9
    v_xor_b32 v15, v131, v9
    v_or3_b32 v12, v12, v13, v14
    v_or_b32 v8, v12, v15
    v_xor_b32 v12, v132, v9
    v_xor_b32 v13, v133, v9
    v_xor_b32 v14, v134, v9
    v_xor_b32 v15, v135, v9
    v_or3_b32 v12, v12, v13, v14
    v_or3_b32 v8, v8, v12, v15
    v_and_b32 v8, s51, v8
    v_cmp_ne_u32 vcc, 0, v8
    s_cbranch_vccnz L_qfail
L_qdone:
    v_and_b32 v128, 0xffffffc0, v128
    v_and_b32 v129, 0xffffffc0, v129
    v_and_b32 v130, 0xffffffc0, v130
    v_and_b32 v131, 0xffffffc0, v131
    v_and_b32 v132, 0xffffffc0, v132
    v_and_b32 v133, 0xffffffc0, v133
    v_and_b32 v134, 0xffffffc0, v134
    v_and_b32 v135, 0xffffffc0, v135
    v_mov_b32 v136, v128
    v_mov_b32 v137, v129
    v_mov_b32 v138, v130
    v_mov_b32 v139, v131
    v_mov_b32 v140, v132
    v_mov_b32 v141, v133
    v_mov_b32 v142, v134
    v_mov_b32 v143, v135
    v_permlane16_swap_b32 v128, v136
    v_permlane16_swap_b32 v129, v137
    v_permlane16_swap_b32 v130, v138
    v_permlane16_swap_b32 v131, v139
    v_permlane16_swap_b32 v132, v140
    v_permlane16_swap_b32 v133, v141
    v_permlane16_swap_b32 v134, v142
    v_permlane16_swap_b32 v135, v143
    v_add_f32 v128, v128, v136
    v_add_f32 v129, v129, v137
    v_add_f32 v130, v130, v138
    v_add_f32 v131, v131, v139
    v_add_f32 v132, v132, v140
    v_add_f32 v133, v133, v141
    v_add_f32 v134, v134, v142
    v_add_f32 v135, v135, v143
    v_mov_b32 v136, v128
    v_mov_b32 v137, v129
    v_mov_b32 v138, v130
    v_mov_b32 v139, v131
    v_mov_b32 v140, v132
    v_mov_b32 v141, v133
    v_mov_b32 v142, v134
    v_mov_b32 v143, v135
    v_permlane32_swap_b32 v128, v136
    v_permlane32_swap_b32 v129, v137
    v_permlane32_swap_b32 v130, v138
    v_permlane32_swap_b32 v131, v139
    v_permlane32_swap_b32 v132, v140
    v_permlane32_swap_b32 v133, v141
    v_permlane32_swap_b32 v134, v142
    v_permlane32_swap_b32 v135, v143
    v_add_f32 v128, v128, v136
    v_add_f32 v129, v129, v137
    v_add_f32 v130, v130, v138
    v_add_f32 v131, v131, v139
    v_add_f32 v132, v132, v140
    v_add_f32 v133, v133, v141
    v_add_f32 v134, v134, v142
    v_add_f32 v135, v135, v143
    v_lshlrev_b32 v4, 1, v2
    v_cvt_pk_bf16_f32 v128, v128, v128
    v_cvt_pk_bf16_f32 v129, v129, v129
    v_cvt_pk_bf16_f32 v130, v130, v130
    v_cvt_pk_bf16_f32 v131, v131, v131
    v_cvt_pk_bf16_f32 v132, v132, v132
    v_cvt_pk_bf16_f32 v133, v133, v133
    v_cvt_pk_bf16_f32 v134, v134, v134
    v_cvt_pk_bf16_f32 v135, v135, v135
    ds_write_b16 v4, v128 offset:17408
    ds_write_b16 v4, v129 offset:17440
    ds_write_b16 v4, v130 offset:17472
    ds_write_b16 v4, v131 offset:17504
    ds_write_b16 v4, v132 offset:17536
    ds_write_b16 v4, v133 offset:17568
    ds_write_b16 v4, v134 offset:17600
    ds_write_b16 v4, v135 offset:17632
    v_mov_b32 v12, s48
    v_mov_b32 v13, s50
    s_waitcnt lgkmcnt(0)
    ds_write_b64 v7, v[12:13] offset:17680
    s_branch L_hjoin
L_qfail:
    s_cmp_gt_u32 s44, 1048576
    s_cbranch_scc1 L_qdone
    s_sleep 4
    s_cmp_lt_u32 s44, 12
    s_cbranch_scc1 L_qpoll
    s_lshl_b32 s3, s31, 7
    s_add_u32 s3, s3, 4096
    s_cmp_lg_u32 s44, 12
    s_cbranch_scc1 L_qflag
    s_mov_b32 exec_lo, 0xffffff
    s_mov_b32 exec_hi, 0
    global_store_dwordx4 v11, v[56:59], s[28:29] sc1
    s_mov_b64 exec, -1
    v_add_u32 v5, 524288, v5
    global_store_dwordx4 v5, v[48:51], s[28:29] sc1
    s_lshl_b32 s52, s32, 2
    s_add_u32 s52, s52, s3
    v_mov_b32 v12, s52
    v_mov_b32 v13, s48
    s_waitcnt vmcnt(0)
    s_mov_b64 exec, 1
    global_store_dword v12, v13, s[28:29] sc1
    s_mov_b64 exec, -1
L_qflag:
    v_and_b32 v12, 7, v0
    v_lshl_add_u32 v12, v12, 2, s3
    global_load_dword v13, v12, s[28:29] sc1
    s_waitcnt vmcnt(0)
    v_cmp_ne_u32 vcc, s48, v13
    s_cbranch_vccz L_qglob
    global_load_dwordx4 v[128:131], v6, s[28:29] offset:0 sc1
    global_load_dwordx4 v[132:135], v6, s[28:29] offset:1024 sc1
    s_branch L_qchk
L_qglob:
    v_add_u32 v6, 524288, v6
    global_load_dwordx4 v[128:131], v6, s[28:29] offset:0 sc1
    global_load_dwordx4 v[132:135], v6, s[28:29] offset:1024 sc1
    s_mov_b32 s50, 1
    s_waitcnt vmcnt(0)
    s_branch L_qdone
L_gelu:
    s_bfe_u32 s34, s2, 0x10005
    s_lshl_b32 s35, s31, 1
    s_add_u32 s35, s35, s34
    s_lshl_b32 s3, s33, 10
    v_lshl_add_u32 v4, v0, 4, s3
    s_lshl_b32 s44, s35, 4
    s_add_u32 s3, s3, s44
    v_and_b32 v5, 7, v0
    v_lshl_add_u32 v5, v5, 1, s3
    s_sub_u32 s47, s30, 5
    s_lshl_b32 s3, s47, 10
    v_lshl_add_u32 v6, v0, 4, s3
    s_mov_b32 s38, 2752
    s_mov_b32 s39, 0x20000
    s_mov_b32 s42, 2752
    s_mov_b32 s43, 0x20000
    s_mov_b32 s54, 2752
    s_mov_b32 s55, 0x20000
    s_waitcnt lgkmcnt(0)
    s_barrier
    s_mov_b32 s36, s16
    s_mov_b32 s37, s17
    s_mov_b32 s40, s18
    s_mov_b32 s41, s19
    s_mov_b32 s52, s20
    s_mov_b32 s53, s21
    global_load_dwordx4 v[16:19], v4, s[4:5]
    global_load_ushort v20, v5, s[4:5]
    buffer_load_dwordx4 v[24:27], v6, s[36:39], 0 offen
    buffer_load_dwordx4 v[28:31], v6, s[40:43], 0 offen
    buffer_load_dwordx4 v[32:35], v6, s[52:55], 0 offen
    s_setprio 0
    s_waitcnt vmcnt(3)
    v_lshlrev_b32 v20, 16, v20
    s_mov_b32 s44, 0
L_ln:
    v_lshlrev_b32 v64, 16, v16
    v_and_b32 v65, 0xffff0000, v16
    v_lshlrev_b32 v66, 16, v17
    v_and_b32 v67, 0xffff0000, v17
    v_lshlrev_b32 v68, 16, v18
    v_and_b32 v69, 0xffff0000, v18
    v_lshlrev_b32 v70, 16, v19
    v_and_b32 v71, 0xffff0000, v19
    v_pk_add_f32 v[36:37], v[64:65], v[66:67]
    v_pk_add_f32 v[38:39], v[68:69], v[70:71]
    v_pk_add_f32 v[36:37], v[36:37], v[38:39]
    v_add_f32 v36, v36, v37
    s_nop 1
    v_add_f32 v36, v36, v36 quad_perm:[1,0,3,2] row_mask:0xf bank_mask:0xf
    s_nop 1
    v_add_f32 v36, v36, v36 quad_perm:[2,3,0,1] row_mask:0xf bank_mask:0xf
    s_nop 1
    v_add_f32 v36, v36, v36 row_ror:4 row_mask:0xf bank_mask:0xf
    s_nop 1
    v_add_f32 v36, v36, v36 row_ror:8 row_mask:0xf bank_mask:0xf
    v_mov_b32 v37, v36
    s_nop 1
    v_permlane16_swap_b32 v36, v37
    v_add_f32 v36, v36, v37
    v_mov_b32 v37, v36
    s_nop 1
    v_permlane32_swap_b32 v36, v37
    v_add_f32 v36, v36, v37
    v_mul_f32 v36, 0x3b000000, v36
    v_mov_b32 v37, v36
    v_pk_add_f32 v[72:73], v[64:65], v[36:37] neg_lo:[0,1] neg_hi:[0,1]
    v_pk_add_f32 v[74:75], v[66:67], v[36:37] neg_lo:[0,1] neg_hi:[0,1]
    v_pk_add_f32 v[76:77], v[68:69], v[36:37] neg_lo:[0,1] neg_hi:[0,1]
    v_pk_add_f32 v[78:79], v[70:71], v[36:37] neg_lo:[0,1] neg_hi:[0,1]
    v_pk_mul_f32 v[38:39], v[72:73], v[72:73]
    v_pk_fma_f32 v[38:39], v[74:75], v[74:75], v[38:39]
    v_pk_fma_f32 v[38:39], v[76:77], v[76:77], v[38:39]
    v_pk_fma_f32 v[38:39], v[78:79], v[78:79], v[38:39]
    v_add_f32 v38, v38, v39
    s_nop 1
    v_add_f32 v38, v38, v38 quad_perm:[1,0,3,2] row_mask:0xf bank_mask:0xf
    s_nop 1
    v_add_f32 v38, v38, v38 quad_perm:[2,3,0,1] row_mask:0xf bank_mask:0xf
    s_nop 1
    v_add_f32 v38, v38, v38 row_ror:4 row_mask:0xf bank_mask:0xf
    s_nop 1
    v_add_f32 v38, v38, v38 row_ror:8 row_mask:0xf bank_mask:0xf
    v_mov_b32 v39, v38
    s_nop 1
    v_permlane16_swap_b32 v38, v39
    v_add_f32 v38, v38, v39
    v_mov_b32 v39, v38
    s_nop 1
    v_permlane32_swap_b32 v38, v39
    v_add_f32 v38, v38, v39
    v_mul_f32 v38, 0x3b000000, v38
    v_cvt_pk_bf16_f32 v36, v36, v36
    v_and_b32 v36, 0xffff0000, v36
    v_cvt_pk_bf16_f32 v38, v38, v38
    v_and_b32 v38, 0xffff0000, v38
    v_add_f32 v38, 0x3727c5ac, v38
    v_cvt_pk_bf16_f32 v38, v38, v38
    v_and_b32 v38, 0xffff0000, v38
    v_sqrt_f32 v38, v38
    s_nop 0
    v_cvt_pk_bf16_f32 v38, v38, v38
    v_and_b32 v38, 0xffff0000, v38
    v_rcp_f32 v38, v38
    v_sub_f32 v64, v64, v36
    v_sub_f32 v65, v65, v36
    v_sub_f32 v66, v66, v36
    v_sub_f32 v67, v67, v36
    v_sub_f32 v68, v68, v36
    v_sub_f32 v69, v69, v36
    v_sub_f32 v70, v70, v36
    v_sub_f32 v71, v71, v36
    v_sub_f32 v20, v20, v36
    v_cvt_pk_bf16_f32 v16, v64, v65
    v_cvt_pk_bf16_f32 v17, v66, v67
    v_cvt_pk_bf16_f32 v18, v68, v69
    v_cvt_pk_bf16_f32 v19, v70, v71
    v_cvt_pk_bf16_f32 v20, v20, v20
    v_and_b32 v20, 0xffff0000, v20
    v_lshlrev_b32 v64, 16, v16
    v_and_b32 v65, 0xffff0000, v16
    v_lshlrev_b32 v66, 16, v17
    v_and_b32 v67, 0xffff0000, v17
    v_lshlrev_b32 v68, 16, v18
    v_and_b32 v69, 0xffff0000, v18
    v_lshlrev_b32 v70, 16, v19
    v_and_b32 v71, 0xffff0000, v19
    v_mul_f32 v64, v64, v38
    v_mul_f32 v65, v65, v38
    v_mul_f32 v66, v66, v38
    v_mul_f32 v67, v67, v38
    v_mul_f32 v68, v68, v38
    v_mul_f32 v69, v69, v38
    v_mul_f32 v70, v70, v38
    v_mul_f32 v71, v71, v38
    v_mul_f32 v20, v20, v38
    v_cvt_pk_bf16_f32 v16, v64, v65
    v_cvt_pk_bf16_f32 v17, v66, v67
    v_cvt_pk_bf16_f32 v18, v68, v69
    v_cvt_pk_bf16_f32 v19, v70, v71
    v_cvt_pk_bf16_f32 v20, v20, v20
    v_and_b32 v20, 0xffff0000, v20
    s_add_u32 s44, s44, 1
    s_cmp_lt_u32 s44, 2
    s_cbranch_scc1 L_ln
    s_waitcnt vmcnt(0)
    v_lshlrev_b32 v64, 16, v24
    v_and_b32 v65, 0xffff0000, v24
    v_lshlrev_b32 v66, 16, v25
    v_and_b32 v67, 0xffff0000, v25
    v_lshlrev_b32 v68, 16, v26
    v_and_b32 v69, 0xffff0000, v26
    v_lshlrev_b32 v70, 16, v27
    v_and_b32 v71, 0xffff0000, v27
    v_lshlrev_b32 v72, 16, v28
    v_and_b32 v73, 0xffff0000, v28
    v_lshlrev_b32 v74, 16, v29
    v_and_b32 v75, 0xffff0000, v29
    v_lshlrev_b32 v76, 16, v30
    v_and_b32 v77, 0xffff0000, v30
    v_lshlrev_b32 v78, 16, v31
    v_and_b32 v79, 0xffff0000, v31
    v_lshlrev_b32 v80, 16, v32
    v_and_b32 v81, 0xffff0000, v32
    v_lshlrev_b32 v82, 16, v33
    v_and_b32 v83, 0xffff0000, v33
    v_lshlrev_b32 v84, 16, v34
    v_and_b32 v85, 0xffff0000, v34
    v_lshlrev_b32 v86, 16, v35
    v_and_b32 v87, 0xffff0000, v35
    v_mov_b32 v40, 0xc0135761
    v_mov_b32 v41, v40
    s_mov_b32 s62, 0xbdd2d3e8
    s_mov_b32 s63, s62
    s_mov_b32 s64, 1.0
    s_mov_b32 s65, 1.0
    s_lshl_b32 s3, s47, 5
    v_mov_b32 v4, s3
    s_mov_b32 s44, 0
L_gl:
    v_readlane_b32 s60, v20, s44
    s_add_u32 s44, s44, 1
    s_mov_b32 s61, s60
    v_pk_mul_f32 v[44:45], v[64:65], s[60:61]
    v_pk_mul_f32 v[46:47], v[66:67], s[60:61]
    v_pk_mul_f32 v[48:49], v[68:69], s[60:61]
    v_pk_mul_f32 v[50:51], v[70:71], s[60:61]
    v_cvt_pk_bf16_f32 v60, v44, v45
    v_cvt_pk_bf16_f32 v61, v46, v47
    v_cvt_pk_bf16_f32 v62, v48, v49
    v_cvt_pk_bf16_f32 v63, v50, v51
    v_lshlrev_b32 v44, 16, v60
    v_and_b32 v45, 0xffff0000, v60
    v_lshlrev_b32 v46, 16, v61
    v_and_b32 v47, 0xffff0000, v61
    v_lshlrev_b32 v48, 16, v62
    v_and_b32 v49, 0xffff0000, v62
    v_lshlrev_b32 v50, 16, v63
    v_and_b32 v51, 0xffff0000, v63
    v_pk_add_f32 v[44:45], v[44:45], v[72:73]
    v_pk_add_f32 v[46:47], v[46:47], v[74:75]
    v_pk_add_f32 v[48:49], v[48:49], v[76:77]
    v_pk_add_f32 v[50:51], v[50:51], v[78:79]
    v_cvt_pk_bf16_f32 v60, v44, v45
    v_cvt_pk_bf16_f32 v61, v46, v47
    v_cvt_pk_bf16_f32 v62, v48, v49
    v_cvt_pk_bf16_f32 v63, v50, v51
    v_lshlrev_b32 v44, 16, v60
    v_and_b32 v45, 0xffff0000, v60
    v_lshlrev_b32 v46, 16, v61
    v_and_b32 v47, 0xffff0000, v61
    v_lshlrev_b32 v48, 16, v62
    v_and_b32 v49, 0xffff0000, v62
    v_lshlrev_b32 v50, 16, v63
    v_and_b32 v51, 0xffff0000, v63
    v_pk_mul_f32 v[52:53], v[44:45], v[44:45]
    v_pk_mul_f32 v[54:55], v[46:47], v[46:47]
    v_pk_mul_f32 v[56:57], v[48:49], v[48:49]
    v_pk_mul_f32 v[58:59], v[50:51], v[50:51]
    v_pk_fma_f32 v[52:53], v[52:53], s[62:63], v[40:41]
    v_pk_fma_f32 v[54:55], v[54:55], s[62:63], v[40:41]
    v_pk_fma_f32 v[56:57], v[56:57], s[62:63], v[40:41]
    v_pk_fma_f32 v[58:59], v[58:59], s[62:63], v[40:41]
    v_pk_mul_f32 v[52:53], v[52:53], v[44:45]
    v_pk_mul_f32 v[54:55], v[54:55], v[46:47]
    v_pk_mul_f32 v[56:57], v[56:57], v[48:49]
    v_pk_mul_f32 v[58:59], v[58:59], v[50:51]
    v_exp_f32 v52, v52
    v_exp_f32 v53, v53
    v_exp_f32 v54, v54
    v_exp_f32 v55, v55
    v_exp_f32 v56, v56
    v_exp_f32 v57, v57
    v_exp_f32 v58, v58
    v_exp_f32 v59, v59
    v_pk_add_f32 v[52:53], v[52:53], s[64:65]
    v_pk_add_f32 v[54:55], v[54:55], s[64:65]
    v_pk_add_f32 v[56:57], v[56:57], s[64:65]
    v_pk_add_f32 v[58:59], v[58:59], s[64:65]
    v_rcp_f32 v52, v52
    v_rcp_f32 v53, v53
    v_rcp_f32 v54, v54
    v_rcp_f32 v55, v55
    v_rcp_f32 v56, v56
    v_rcp_f32 v57, v57
    v_rcp_f32 v58, v58
    v_rcp_f32 v59, v59
    v_pk_mul_f32 v[44:45], v[44:45], v[52:53]
    v_pk_mul_f32 v[46:47], v[46:47], v[54:55]
    v_pk_mul_f32 v[48:49], v[48:49], v[56:57]
    v_pk_mul_f32 v[50:51], v[50:51], v[58:59]
    v_cvt_pk_bf16_f32 v60, v44, v45
    v_cvt_pk_bf16_f32 v61, v46, v47
    v_cvt_pk_bf16_f32 v62, v48, v49
    v_cvt_pk_bf16_f32 v63, v50, v51
    v_lshlrev_b32 v44, 16, v60
    v_and_b32 v45, 0xffff0000, v60
    v_lshlrev_b32 v46, 16, v61
    v_and_b32 v47, 0xffff0000, v61
    v_lshlrev_b32 v48, 16, v62
    v_and_b32 v49, 0xffff0000, v62
    v_lshlrev_b32 v50, 16, v63
    v_and_b32 v51, 0xffff0000, v63
    v_pk_mul_f32 v[42:43], v[44:45], v[80:81]
    v_pk_fma_f32 v[42:43], v[46:47], v[82:83], v[42:43]
    v_pk_fma_f32 v[42:43], v[48:49], v[84:85], v[42:43]
    v_pk_fma_f32 v[42:43], v[50:51], v[86:87], v[42:43]
    v_add_f32 v42, v42, v43
    s_nop 1
    v_add_f32 v42, v42, v42 quad_perm:[1,0,3,2] row_mask:0xf bank_mask:0xf
    s_nop 1
    v_add_f32 v42, v42, v42 quad_perm:[2,3,0,1] row_mask:0xf bank_mask:0xf
    s_nop 1
    v_add_f32 v42, v42, v42 row_ror:4 row_mask:0xf bank_mask:0xf
    s_nop 1
    v_add_f32 v42, v42, v42 row_ror:8 row_mask:0xf bank_mask:0xf
    v_mov_b32 v43, v42
    s_nop 1
    v_permlane16_swap_b32 v42, v43
    v_add_f32 v42, v42, v43
    v_mov_b32 v43, v42
    s_nop 1
    v_permlane32_swap_b32 v42, v43
    v_add_f32 v42, v42, v43
    ds_write_b32 v4, v42 offset:17728
    v_add_u32 v4, 4, v4
    s_cmp_lt_u32 s44, 8
    s_cbranch_scc1 L_gl
L_hjoin:
    s_setprio 0
    s_bfe_u32 s34, s2, 0x10005
    s_lshl_b32 s35, s31, 1
    s_add_u32 s35, s35, s34
    v_lshrrev_b32 v4, 2, v2
    v_lshl_add_u32 v4, v3, 3, v4
    v_lshlrev_b32 v4, 7, v4
    v_and_b32 v5, 3, v0
    v_lshl_or_b32 v4, v5, 3, v4
    s_lshl_b32 s3, s45, 5
    v_add_u32 v4, s3, v4
    v_lshrrev_b32 v6, 5, v0
    v_lshlrev_b32 v6, 8, v6
    v_bfe_u32 v8, v0, 2, 1
    v_lshl_or_b32 v6, v8, 7, v6
    v_bfe_u32 v8, v0, 3, 2
    v_lshl_or_b32 v6, v8, 5, v6
    v_lshl_or_b32 v6, v5, 3, v6
    s_lshl_b32 s44, s32, 10
    s_add_u32 s44, s44, s46
    v_lshrrev_b32 v8, 1, v2
    v_lshlrev_b32 v8, 10, v8
    v_and_b32 v9, 1, v0
    v_lshl_or_b32 v9, v3, 1, v9
    v_lshl_or_b32 v9, v9, 4, v8
    v_add_u32 v9, s46, v9
    v_lshl_add_u32 v8, v3, 11, s46
    v_lshl_add_u32 v5, v0, 2, s44
    s_lshl_b32 s3, s32, 2
    s_add_u32 s3, s3, s45
    s_lshl_b32 s3, s3, 11
    s_and_b32 s44, s31, 7
    s_lshl_b32 s44, s44, 8
    s_add_u32 s3, s3, s44
    s_lshr_b32 s44, s31, 3
    s_lshl_b32 s44, s44, 6
    s_add_u32 s3, s3, s44
    s_add_u32 s3, s3, 524288
    v_lshlrev_b32 v10, 16, v3
    v_lshl_or_b32 v10, v2, 2, v10
    v_add_u32 v10, s3, v10
    s_movk_i32 s59, 0x3ff
    s_mov_b32 s58, 1048576
    s_mov_b32 s44, 0
    global_load_dword v99, v10, s[28:29]
    s_cmp_lg_u32 s45, 0
    s_cbranch_scc1 L_hb2
    v_and_b32 v11, 1, v0
    v_bfe_u32 v12, v0, 1, 1
    v_lshl_or_b32 v12, v11, 1, v12
    s_lshl_b32 s3, s33, 10
    s_lshl_b32 s52, s35, 4
    s_add_u32 s3, s3, s52
    v_lshl_add_u32 v80, v12, 2, s3
    v_lshlrev_b32 v92, 3, v12
    global_load_dword v82, v80, s[4:5]
    global_load_ushort v83, v7, s[22:23]
    s_lshl_b32 s3, s33, 16
    s_lshl_b32 s52, s31, 11
    s_add_u32 s3, s3, s52
    s_lshl_b32 s52, s34, 5
    s_add_u32 s3, s3, s52
    s_add_u32 s3, s3, 524288
    v_lshrrev_b32 v81, 1, v0
    v_lshlrev_b32 v81, 6, v81
    v_lshl_or_b32 v81, v11, 4, v81
    v_add_u32 v81, s3, v81
    s_mov_b32 s54, 0xcccccccc
    s_mov_b32 s55, s54
L_lw:
    s_sleep 4
    ds_read_b128 v[24:27], v7 offset:17696
    ds_read_b32 v14, v7 offset:17712
    s_waitcnt lgkmcnt(0)
    v_max3_u32 v12, v24, v25, v26
    v_max_u32 v12, v12, v27
    v_cmp_eq_u32 vcc, -1, v12
    s_cbranch_vccnz L_lw
    v_add_f32 v24, v24, v25
    v_add_f32 v26, v26, v27
    v_add_f32 v24, v24, v26
    v_log_f32 v12, v24
    v_rcp_f32 v62, v24
    s_mov_b32 exec_hi, 0
    v_add_f32 v12, v12, v14
    v_min_u32 v12, -2, v12
    s_cmp_lg_u32 s50, 0
    s_cbranch_scc1 L_wst1
    global_store_dword v5, v12, s[28:29] offset:256
    s_branch L_wst2
L_wst1:
    global_store_dword v5, v12, s[28:29] offset:256 sc1
L_wst2:
    s_mov_b64 exec, -1
    s_waitcnt vmcnt(1)
    v_lshlrev_b32 v86, 16, v83
    v_and_b32 v83, 0xffff0000, v82
    v_lshlrev_b32 v82, 16, v82
    v_add_u32 v6, 18432, v6
    v_add_u32 v95, 2048, v6
    s_and_b32 s3, s48, s59
    v_mov_b32 v63, v62
    v_mov_b32 v61, s3
    v_mov_b32 v93, s48
    s_setprio 3
    s_cmp_lg_u32 s50, 0
    s_barrier
    ds_read2_b64 v[16:19], v6 offset0:0 offset1:64
    ds_read2_b64 v[20:23], v6 offset0:128 offset1:192
    ds_read2_b64 v[24:27], v95 offset0:0 offset1:64
    ds_read2_b64 v[28:31], v95 offset0:128 offset1:192
    s_waitcnt lgkmcnt(2)
    v_pk_add_f32 v[16:17], v[16:17], v[18:19]
    v_pk_add_f32 v[20:21], v[20:21], v[22:23]
    s_waitcnt lgkmcnt(1)
    v_pk_add_f32 v[16:17], v[16:17], v[20:21]
    v_pk_add_f32 v[24:25], v[24:25], v[26:27]
    s_waitcnt lgkmcnt(0)
    v_pk_add_f32 v[28:29], v[28:29], v[30:31]
    v_pk_add_f32 v[16:17], v[16:17], v[24:25]
    v_pk_add_f32 v[16:17], v[16:17], v[28:29]
    v_pk_mul_f32 v[16:17], v[16:17], v[62:63]
    v_cvt_pk_bf16_f32 v16, v16, v17
    v_min_u32 v16, -2, v16
    s_cbranch_scc1 L_ost1
    global_store_dword v5, v16, s[28:29]
L_ost2:
    s_barrier
    global_load_dwordx4 v[16:19], v9, s[28:29] nt
    global_load_dwordx4 v[20:23], v9, s[28:29] offset:128 nt
    global_load_dword v12, v8, s[28:29] offset:256 nt
    global_load_dword v13, v8, s[28:29] offset:1280 nt
    ds_read_b64_tr_b16 v[64:65], v4 offset:0
    ds_read_b64_tr_b16 v[66:67], v4 offset:512
    ds_read_b64_tr_b16 v[68:69], v4 offset:4096
    ds_read_b64_tr_b16 v[70:71], v4 offset:4608
    ds_read_b64_tr_b16 v[72:73], v4 offset:8192
    ds_read_b64_tr_b16 v[74:75], v4 offset:8704
    ds_read_b64_tr_b16 v[76:77], v4 offset:12288
    ds_read_b64_tr_b16 v[78:79], v4 offset:12800
L_opoll:
    s_add_u32 s44, s44, 1
    s_waitcnt vmcnt(0) lgkmcnt(0)
    v_mfma_f32_16x16x32_bf16 v[24:27], v[16:19], v[64:67], 0
    v_max3_u32 v14, v16, v17, v18
    v_max3_u32 v15, v19, v20, v21
    v_mfma_f32_16x16x32_bf16 v[28:31], v[16:19], v[68:71], 0
    v_max3_u32 v14, v14, v22, v23
    v_max3_u32 v15, v15, v12, v13
    v_mfma_f32_16x16x32_bf16 v[24:27], v[20:23], v[72:75], v[24:27]
    v_max_u32 v14, v14, v15
    v_max_f32 v34, v12, v13
    v_mfma_f32_16x16x32_bf16 v[28:31], v[20:23], v[76:79], v[28:31]
    v_cmp_eq_u32 vcc, -1, v14
    v_sub_f32 v32, v12, v34
    v_sub_f32 v33, v13, v34
    s_cbranch_vccnz L_oagain
L_odone:
    v_exp_f32 v32, v32
    v_exp_f32 v33, v33
    s_cmp_lg_u32 s45, 0
    v_add_f32 v34, v32, v33
    v_rcp_f32 v34, v34
    v_add_f32 v24, v24, v29
    v_add_f32 v26, v26, v31
    v_mul_f32 v60, v24, v32
    v_fmac_f32 v60, v26, v33
    v_mul_f32 v60, v60, v34
    v_bfi_b32 v60, s59, v61, v60
    global_store_dword v10, v60, s[28:29] sc1
    s_cbranch_scc1 L_hexit
    ds_read_b64 v[84:85], v92 offset:17728
    ds_read_b64 v[88:89], v92 offset:17760
    ds_read_b64 v[96:97], v92 offset:17792
    s_mov_b32 s44, 0
    s_waitcnt lgkmcnt(0)
    v_add_f32 v84, v84, v88
    v_add_f32 v85, v85, v89
    v_add_f32 v84, v84, v96
    v_add_f32 v85, v85, v97
    v_cvt_pk_bf16_f32 v84, v84, v85
    v_and_b32 v85, 0xffff0000, v84
    v_lshlrev_b32 v84, 16, v84
    v_add_f32 v84, v84, v86
    v_add_f32 v85, v85, v86
    v_cvt_pk_bf16_f32 v84, v84, v85
    v_and_b32 v85, 0xffff0000, v84
    v_lshlrev_b32 v84, 16, v84
    s_sleep 14
    global_load_dwordx4 v[24:27], v81, s[28:29] sc1
L_ypoll:
    s_waitcnt vmcnt(0)
    v_xor_b32 v12, v24, v61
    v_xor_b32 v13, v25, v61
    v_xor_b32 v14, v26, v61
    v_xor_b32 v15, v27, v61
    v_or3_b32 v16, v12, v13, v14
    v_or_b32 v16, v16, v15
    v_and_b32 v16, s59, v16
    v_cmp_ne_u32 vcc, 0, v16
    s_cbranch_vccnz L_yagain
L_ydone:
    s_mov_b64 exec, -1
    v_cndmask_b32 v21, v14, v12, s[54:55]
    v_cndmask_b32 v23, v15, v13, s[54:55]
    v_cndmask_b32 v20, v12, v14, s[54:55]
    v_cndmask_b32 v22, v13, v15, s[54:55]
    s_nop 0
    v_add_f32 v20, v21, v20 quad_perm:[2,3,0,1] row_mask:0xf bank_mask:0xf
    v_add_f32 v22, v23, v22 quad_perm:[2,3,0,1] row_mask:0xf bank_mask:0xf
    s_nop 0
    v_add_f32 v20, v20, v20 row_ror:4 row_mask:0xf bank_mask:0xf
    v_add_f32 v22, v22, v22 row_ror:4 row_mask:0xf bank_mask:0xf
    s_nop 0
    v_add_f32 v20, v20, v20 row_ror:8 row_mask:0xf bank_mask:0xf
    v_add_f32 v22, v22, v22 row_ror:8 row_mask:0xf bank_mask:0xf
    v_mov_b32 v21, v20
    v_mov_b32 v23, v22
    s_nop 0
    v_permlane16_swap_b32 v20, v21
    v_permlane16_swap_b32 v22, v23
    v_add_f32 v20, v20, v21
    v_add_f32 v22, v22, v23
    v_mov_b32 v21, v20
    v_mov_b32 v23, v22
    s_nop 0
    v_permlane32_swap_b32 v20, v21
    v_permlane32_swap_b32 v22, v23
    v_add_f32 v20, v20, v21
    v_add_f32 v22, v22, v23
    v_cvt_pk_bf16_f32 v20, v20, v22
    v_and_b32 v22, 0xffff0000, v20
    v_lshlrev_b32 v20, 16, v20
    v_add_f32 v20, v20, v82
    v_add_f32 v22, v22, v83
    v_cvt_pk_bf16_f32 v20, v20, v22
    v_and_b32 v22, 0xffff0000, v20
    v_lshlrev_b32 v20, 16, v20
    v_add_f32 v20, v20, v84
    v_add_f32 v22, v22, v85
    v_cvt_pk_bf16_f32 v20, v20, v22
    s_mov_b64 exec, 15
    global_store_dword v80, v20, s[24:25]
    s_cmp_lg_u32 s2, 0
    s_cbranch_scc1 L_hexit
    s_mov_b64 exec, 1
    global_store_dword v7, v93, s[28:29]
L_hexit:
    s_endpgm
L_hb2:
    s_waitcnt lgkmcnt(0)
    s_barrier
    ds_read_b32 v61, v7 offset:17680
    s_branch L_ost2
L_ost1:
    global_store_dword v5, v16, s[28:29] sc1
    s_branch L_ost2
L_oagain:
    s_cmp_gt_u32 s44, s58
    s_cbranch_scc1 L_odone
    s_cmp_gt_u32 s44, 24
    s_cbranch_scc1 L_oslow
    v_max_u32 v15, v12, v13
    global_load_dwordx4 v[16:19], v9, s[28:29] nt
    v_cmp_eq_u32 vcc, -1, v15
    global_load_dwordx4 v[20:23], v9, s[28:29] offset:128 nt
    s_cbranch_vccz L_opoll
    global_load_dword v12, v8, s[28:29] offset:256 nt
    global_load_dword v13, v8, s[28:29] offset:1280 nt
    s_branch L_opoll
L_oslow:
    global_load_dwordx4 v[16:19], v9, s[28:29] sc1
    global_load_dwordx4 v[20:23], v9, s[28:29] offset:128 sc1
    global_load_dword v12, v8, s[28:29] offset:256 sc1
    global_load_dword v13, v8, s[28:29] offset:1280 sc1
    s_branch L_opoll
L_yagain:
    s_and_b64 exec, exec, vcc
    s_add_u32 s44, s44, 1
    s_cmp_gt_u32 s44, s58
    s_cbranch_scc1 L_ydone
    s_bcnt1_i32_b64 s3, exec
    s_cmp_le_u32 s3, 8
    s_cbranch_scc1 L_yf
    s_sleep 3
L_yf:
    global_load_dwordx4 v[24:27], v81, s[28:29] sc1
    s_branch L_ypoll
L_end:
    s_endpgm
.section .rodata,"a"
.p2align 6
.amdhsa_kernel parallel_sum__sliding_block_cached__mixer_token_mlp__decode_kernel
  .amdhsa_next_free_vgpr 256
  .amdhsa_next_free_sgpr 102
  .amdhsa_accum_offset 256
  .amdhsa_group_segment_fixed_size 0
  .amdhsa_kernarg_size 104
  .amdhsa_user_sgpr_count 2
  .amdhsa_user_sgpr_kernarg_segment_ptr 1
  .amdhsa_system_sgpr_workgroup_id_x 1
  .amdhsa_float_denorm_mode_32 3
.end_amdhsa_kernel
```
